```python
import torch

def _softmax(x, axis=-1):
    return torch.softmax(x, dim=axis)
def _gelu(x):
    return torch.nn.functional.gelu(x, approximate="tanh")
def _silu(x):
    return torch.nn.functional.silu(x)
def _sigmoid(x):
    return torch.sigmoid(x)
def _layernorm(x, axis=-1, eps=1e-5):
    m = x.mean(dim=axis, keepdim=True)
    v = x.var(dim=axis, keepdim=True, unbiased=False)
    return (x - m) / torch.sqrt(v + eps)
def _scatter_add(tgt, idx, src, axis=0):
    return tgt.clone().index_add_(axis, idx, src)
def _segment_sum(src, seg, n):
    out = torch.zeros((n,) + src.shape[1:], dtype=src.dtype)
    return out.index_add_(0, seg, src)
def _pad(x, pw):
    flat = tuple(v for pair in reversed(pw) for v in pair)
    return torch.nn.functional.pad(x, flat)

kernel_name = 'standalone__gqa_softmax__sampling'

def setup_inputs():

    _w = (lambda a: (lambda t: t.to(torch.bfloat16) if t.is_floating_point() else t)(torch.as_tensor(a)))
    B, Hq, Hkv, Sq, Sk, D = 8, 32, 8, 4, 8192, 128
    return {
        "q": _w((lambda *s: torch.randn(*s, dtype=torch.bfloat16) * 0.8)(B, Hq, Sq, D)),
        "k": _w((lambda *s: torch.randn(*s, dtype=torch.bfloat16) * 0.8)(B, Hkv, Sk, D)),
        "v": _w((lambda *s: torch.randn(*s, dtype=torch.bfloat16) * 0.05)(B, Hkv, Sk, D)),
    }

def reference(q, k, v):
    B, Hq, Sq, D = q.shape
    Hkv = k.shape[1]
    rep = Hq // Hkv
    k = (lambda x, n, axis: torch.repeat_interleave(x, n, dim=axis))(k, rep, axis=1)
    v = (lambda x, n, axis: torch.repeat_interleave(x, n, dim=axis))(v, rep, axis=1)
    scale = D ** -0.5
    scores = torch.einsum("bhqd,bhkd->bhqk", q, k) * scale
    p = _softmax(scores, axis=-1)
    return torch.einsum("bhqk,bhkd->bhqd", p, v)
```

```asm
; @launch grid=(256,1,1) block=(192,1,1) lds=9232
.amdgcn_target "amdgcn-amd-amdhsa--gfx950"
.text
.globl standalone__gqa_softmax__sampling_kernel
.p2align 8
.type standalone__gqa_softmax__sampling_kernel,@function
standalone__gqa_softmax__sampling_kernel:
s_load_dwordx8 s[4:11], s[0:1], 0
s_load_dwordx4 s[12:15], s[0:1], 32
s_cmpk_ge_u32 s2, 256
s_cbranch_scc1 L_end
v_lshrrev_b32 v1, 6, v0
v_and_b32 v0, 63, v0
s_lshr_b32 s41, s2, 1
s_xor_b32 s40, s41, s2
s_and_b32 s40, s40, 1
s_lshr_b32 s45, s2, 3
s_lshl_b32 s45, s45, 1
s_or_b32 s40, s40, s45
s_and_b32 s41, s41, 3
v_readfirstlane_b32 s42, v1
v_and_b32 v2, 15, v0
v_lshrrev_b32 v3, 4, v0
s_cmp_eq_u32 s42, 2
s_cbranch_scc1 L_helper
s_lshl_b32 s44, s40, 21
s_mul_i32 s74, s41, 2
s_add_u32 s74, s74, s42
s_lshr_b32 s83, s40, 3
s_mul_i32 s83, s83, 32
v_and_b32 v78, 3, v2
v_lshlrev_b32 v78, 10, v78
v_lshrrev_b32 v79, 2, v2
v_lshl_add_u32 v78, v79, 8, v78
v_lshl_add_u32 v84, v3, 4, v78
s_lshl_b32 s19, 1, 17
s_lshl_b32 s18, 1, 21
s_add_u32 s76, s74, s83
s_and_b32 s76, s76, 255
s_lshl_b32 s76, s76, 13
s_add_u32 s77, s76, 0x1000
s_waitcnt lgkmcnt(0)
s_add_u32 s16, s6, s44
s_addc_u32 s17, s7, 0
buffer_load_dwordx4 v[180:183], v84, s[16:19], s76 offen offset:0 nt
buffer_load_dwordx4 v[184:187], v84, s[16:19], s76 offen offset:64 nt
buffer_load_dwordx4 v[188:191], v84, s[16:19], s76 offen offset:128 nt
buffer_load_dwordx4 v[192:195], v84, s[16:19], s76 offen offset:192 nt
buffer_load_dwordx4 v[196:199], v84, s[16:19], s77 offen offset:0 nt
buffer_load_dwordx4 v[200:203], v84, s[16:19], s77 offen offset:64 nt
buffer_load_dwordx4 v[204:207], v84, s[16:19], s77 offen offset:128 nt
buffer_load_dwordx4 v[208:211], v84, s[16:19], s77 offen offset:192 nt
v_lshlrev_b32 v89, 4, v0
s_mul_i32 s49, s40, 20480
s_mov_b32 s35, 0x20000
s_mov_b32 s34, 20480
s_lshl_b32 s46, s42, 7
v_xor_b32 v88, s46, v89
v_lshlrev_b32 v1, 8, v2
v_lshl_add_u32 v1, v3, 4, v1
s_mov_b64 s[22:23], s[18:19]
s_mov_b32 s27, s19
s_movk_i32 s26, 0x1000
s_lshl_b32 s48, s40, 12
s_add_u32 s24, s4, s48
s_addc_u32 s25, s5, 0
s_add_u32 s20, s8, s44
s_addc_u32 s21, s9, 0
buffer_load_dwordx4 v[4:7], v1, s[24:27], 0 offen offset:0
buffer_load_dwordx4 v[8:11], v1, s[24:27], 0 offen offset:64
buffer_load_dwordx4 v[12:15], v1, s[24:27], 0 offen offset:128
buffer_load_dwordx4 v[16:19], v1, s[24:27], 0 offen offset:192
buffer_load_dwordx4 v[116:119], v88, s[20:23], s76 offen offset:0 nt
buffer_load_dwordx4 v[120:123], v88, s[20:23], s76 offen offset:1024 nt
buffer_load_dwordx4 v[124:127], v88, s[20:23], s76 offen offset:2048 nt
buffer_load_dwordx4 v[128:131], v88, s[20:23], s76 offen offset:3072 nt
buffer_load_dwordx4 v[132:135], v88, s[20:23], s77 offen offset:0 nt
buffer_load_dwordx4 v[136:139], v88, s[20:23], s77 offen offset:1024 nt
buffer_load_dwordx4 v[140:143], v88, s[20:23], s77 offen offset:2048 nt
buffer_load_dwordx4 v[144:147], v88, s[20:23], s77 offen offset:3072 nt
s_add_u32 s74, s74, 8
L_p1:
s_lshl_b32 s45, s40, 2
s_add_u32 s84, s12, s45
s_addc_u32 s85, s13, 0
s_mov_b32 s86, 4
s_mov_b32 s87, 0x20000
s_cmp_eq_u32 s42, 0
s_cselect_b32 s82, 31, 0
v_mov_b32 v95, 1
s_add_u32 s28, s10, s48
s_addc_u32 s29, s11, 0
s_movk_i32 s30, 0x1000
s_mov_b32 s31, 0x20000
s_add_u32 s32, s14, s49
s_addc_u32 s33, s15, 0
s_mov_b32 s50, 0x05040100
s_mov_b32 s51, 0x07060302
s_mov_b32 s53, 0xfffffffe
s_mov_b32 s52, 0x3e0293ee
v_mov_b32 v20, 0
v_mov_b32 v21, 0
v_mov_b32 v22, 0
v_mov_b32 v23, 0
v_mov_b32 v24, 0
v_mov_b32 v25, 0
v_mov_b32 v26, 0
v_mov_b32 v27, 0
v_mov_b32 v28, 0
v_mov_b32 v29, 0
v_mov_b32 v30, 0
v_mov_b32 v31, 0
v_mov_b32 v32, 0
v_mov_b32 v33, 0
v_mov_b32 v34, 0
v_mov_b32 v35, 0
v_mov_b32 v36, 0
v_mov_b32 v37, 0
v_mov_b32 v38, 0
v_mov_b32 v39, 0
v_mov_b32 v40, 0
v_mov_b32 v41, 0
v_mov_b32 v42, 0
v_mov_b32 v43, 0
v_mov_b32 v44, 0
v_mov_b32 v45, 0
v_mov_b32 v46, 0
v_mov_b32 v47, 0
v_mov_b32 v48, 0
v_mov_b32 v49, 0
v_mov_b32 v50, 0
v_mov_b32 v51, 0
v_mov_b32 v76, 0xff800000
v_mov_b32 v82, 0xff800000
v_mov_b32 v77, 0
s_mov_b32 s43, 0
s_mov_b32 s75, 0
L_p2:
s_lshl_b32 s54, s42, 12
v_add_u32 v96, s54, v89
v_add_u32 v96, 0, v96
s_mul_i32 s54, s42, 2048
v_add_u32 v101, s54, v89
v_xor_b32 v97, 0x1000, v96
s_lshl_b32 s54, s42, 9
s_add_u32 s54, s54, 8192
v_lshl_add_u32 v98, v0, 3, s54
v_xor_b32 v99, 0x200, v98
v_mov_b32 v100, 9216
v_lshlrev_b32 v102, 3, v2
v_add_u32 v102, 4096, v102
v_lshlrev_b32 v103, 8, v2
v_lshl_add_u32 v103, v3, 4, v103
v_add_u32 v103, s46, v103
s_add_u32 s88, s41, 0
s_and_b32 s88, s88, 3
s_mul_i32 s88, s88, 5120
s_add_u32 s89, s41, 1
s_and_b32 s89, s89, 3
s_mul_i32 s89, s89, 5120
s_add_u32 s90, s41, 2
s_and_b32 s90, s90, 3
s_mul_i32 s90, s90, 5120
s_add_u32 s91, s41, 3
s_and_b32 s91, s91, 3
s_mul_i32 s91, s91, 5120
s_cbranch_execz L_hmid
L_loop:
s_add_u32 s43, s43, 1
s_add_u32 s76, s74, s83
s_and_b32 s76, s76, 255
s_lshl_b32 s76, s76, 13
s_add_u32 s77, s76, 0x1000
s_cmp_lg_u32 s43, s82
s_waitcnt vmcnt(8)
s_cbranch_scc1 L_nocl
buffer_atomic_add v95, v89, s[84:87], 0 offen sc0 sc1
L_nocl:
buffer_load_dwordx4 v[212:215], v84, s[16:19], s76 offen offset:0 nt
buffer_load_dwordx4 v[216:219], v84, s[16:19], s76 offen offset:64 nt
buffer_load_dwordx4 v[220:223], v84, s[16:19], s76 offen offset:128 nt
buffer_load_dwordx4 v[224:227], v84, s[16:19], s76 offen offset:192 nt
buffer_load_dwordx4 v[228:231], v84, s[16:19], s77 offen offset:0 nt
buffer_load_dwordx4 v[232:235], v84, s[16:19], s77 offen offset:64 nt
buffer_load_dwordx4 v[236:239], v84, s[16:19], s77 offen offset:128 nt
buffer_load_dwordx4 v[240:243], v84, s[16:19], s77 offen offset:192 nt
L_nok0:
s_add_u32 s74, s74, 8
v_mfma_f32_16x16x32_bf16 v[52:55], v[180:183], v[4:7], 0
v_mfma_f32_16x16x32_bf16 v[56:59], v[196:199], v[4:7], 0
v_mfma_f32_16x16x32_bf16 v[52:55], v[184:187], v[8:11], v[52:55]
v_mfma_f32_16x16x32_bf16 v[56:59], v[200:203], v[8:11], v[56:59]
v_mfma_f32_16x16x32_bf16 v[52:55], v[188:191], v[12:15], v[52:55]
v_mfma_f32_16x16x32_bf16 v[56:59], v[204:207], v[12:15], v[56:59]
v_mfma_f32_16x16x32_bf16 v[52:55], v[192:195], v[16:19], v[52:55]
v_mfma_f32_16x16x32_bf16 v[56:59], v[208:211], v[16:19], v[56:59]
s_nop 6
v_max3_f32 v78, v52, v53, v54
v_max3_f32 v78, v78, v55, v76
v_max3_f32 v79, v56, v57, v58
v_max3_f32 v78, v78, v59, v79
v_mov_b32 v79, v78
s_nop 1
v_permlane32_swap_b32 v78, v79
v_max_f32 v78, v78, v79
v_mov_b32 v79, v78
s_nop 1
v_permlane16_swap_b32 v78, v79
v_max_f32 v76, v78, v79
v_mul_f32 v78, s52, v76
v_sub_f32 v80, v82, v78
v_mov_b32 v82, v78
v_exp_f32 v80, v80
v_fma_f32 v52, v52, s52, -v82
v_fma_f32 v53, v53, s52, -v82
v_fma_f32 v54, v54, s52, -v82
v_fma_f32 v55, v55, s52, -v82
v_fma_f32 v56, v56, s52, -v82
v_fma_f32 v57, v57, s52, -v82
v_fma_f32 v58, v58, s52, -v82
v_fma_f32 v59, v59, s52, -v82
L_ma0:
v_exp_f32 v52, v52
v_exp_f32 v53, v53
v_exp_f32 v54, v54
v_exp_f32 v55, v55
v_exp_f32 v56, v56
v_exp_f32 v57, v57
v_exp_f32 v58, v58
v_exp_f32 v59, v59
v_pk_mul_f32 v[20:21], v[20:21], v[80:81] op_sel_hi:[1,0]
v_pk_mul_f32 v[22:23], v[22:23], v[80:81] op_sel_hi:[1,0]
v_pk_mul_f32 v[24:25], v[24:25], v[80:81] op_sel_hi:[1,0]
v_pk_mul_f32 v[26:27], v[26:27], v[80:81] op_sel_hi:[1,0]
v_pk_mul_f32 v[28:29], v[28:29], v[80:81] op_sel_hi:[1,0]
v_pk_mul_f32 v[30:31], v[30:31], v[80:81] op_sel_hi:[1,0]
v_pk_mul_f32 v[32:33], v[32:33], v[80:81] op_sel_hi:[1,0]
v_pk_mul_f32 v[34:35], v[34:35], v[80:81] op_sel_hi:[1,0]
v_pk_mul_f32 v[36:37], v[36:37], v[80:81] op_sel_hi:[1,0]
v_pk_mul_f32 v[38:39], v[38:39], v[80:81] op_sel_hi:[1,0]
v_pk_mul_f32 v[40:41], v[40:41], v[80:81] op_sel_hi:[1,0]
v_pk_mul_f32 v[42:43], v[42:43], v[80:81] op_sel_hi:[1,0]
v_pk_mul_f32 v[44:45], v[44:45], v[80:81] op_sel_hi:[1,0]
v_pk_mul_f32 v[46:47], v[46:47], v[80:81] op_sel_hi:[1,0]
v_pk_mul_f32 v[48:49], v[48:49], v[80:81] op_sel_hi:[1,0]
v_pk_mul_f32 v[50:51], v[50:51], v[80:81] op_sel_hi:[1,0]
v_add_f32 v78, v52, v53
v_add_f32 v79, v54, v55
v_fma_f32 v77, v77, v80, v56
v_add_f32 v78, v78, v57
v_add_f32 v79, v79, v58
v_add_f32 v77, v77, v59
v_cvt_pk_bf16_f32 v60, v52, v53
v_cvt_pk_bf16_f32 v61, v54, v55
v_cvt_pk_bf16_f32 v62, v56, v57
v_cvt_pk_bf16_f32 v63, v58, v59
v_add_f32 v78, v78, v79
v_add_f32 v77, v77, v78
s_cbranch_execz L_pv0
s_waitcnt vmcnt(8)
buffer_load_dwordx4 v[148:151], v88, s[20:23], s76 offen offset:0 nt
buffer_load_dwordx4 v[152:155], v88, s[20:23], s76 offen offset:1024 nt
buffer_load_dwordx4 v[156:159], v88, s[20:23], s76 offen offset:2048 nt
buffer_load_dwordx4 v[160:163], v88, s[20:23], s76 offen offset:3072 nt
buffer_load_dwordx4 v[164:167], v88, s[20:23], s77 offen offset:0 nt
buffer_load_dwordx4 v[168:171], v88, s[20:23], s77 offen offset:1024 nt
buffer_load_dwordx4 v[172:175], v88, s[20:23], s77 offen offset:2048 nt
buffer_load_dwordx4 v[176:179], v88, s[20:23], s77 offen offset:3072 nt
L_pv0:
v_perm_b32 v64, v120, v116, s50
v_perm_b32 v65, v128, v124, s50
v_perm_b32 v66, v136, v132, s50
v_perm_b32 v67, v144, v140, s50
v_perm_b32 v68, v120, v116, s51
v_perm_b32 v69, v128, v124, s51
v_perm_b32 v70, v136, v132, s51
v_perm_b32 v71, v144, v140, s51
v_mfma_f32_16x16x32_bf16 v[20:23], v[64:67], v[60:63], v[20:23]
v_perm_b32 v72, v121, v117, s50
v_perm_b32 v73, v129, v125, s50
v_perm_b32 v74, v137, v133, s50
v_perm_b32 v75, v145, v141, s50
v_mfma_f32_16x16x32_bf16 v[24:27], v[68:71], v[60:63], v[24:27]
v_perm_b32 v64, v121, v117, s51
v_perm_b32 v65, v129, v125, s51
v_perm_b32 v66, v137, v133, s51
v_perm_b32 v67, v145, v141, s51
v_mfma_f32_16x16x32_bf16 v[28:31], v[72:75], v[60:63], v[28:31]
L_mb0:
v_perm_b32 v68, v122, v118, s50
v_perm_b32 v69, v130, v126, s50
v_perm_b32 v70, v138, v134, s50
v_perm_b32 v71, v146, v142, s50
v_mfma_f32_16x16x32_bf16 v[32:35], v[64:67], v[60:63], v[32:35]
v_perm_b32 v72, v122, v118, s51
v_perm_b32 v73, v130, v126, s51
v_perm_b32 v74, v138, v134, s51
v_perm_b32 v75, v146, v142, s51
v_mfma_f32_16x16x32_bf16 v[36:39], v[68:71], v[60:63], v[36:39]
v_perm_b32 v64, v123, v119, s50
v_perm_b32 v65, v131, v127, s50
v_perm_b32 v66, v139, v135, s50
v_perm_b32 v67, v147, v143, s50
v_mfma_f32_16x16x32_bf16 v[40:43], v[72:75], v[60:63], v[40:43]
v_perm_b32 v68, v123, v119, s51
v_perm_b32 v69, v131, v127, s51
v_perm_b32 v70, v139, v135, s51
v_perm_b32 v71, v147, v143, s51
v_mfma_f32_16x16x32_bf16 v[44:47], v[64:67], v[60:63], v[44:47]
s_cmp_lt_u32 s43, 32
v_mfma_f32_16x16x32_bf16 v[48:51], v[68:71], v[60:63], v[48:51]
s_add_u32 s43, s43, 1
s_add_u32 s76, s74, s83
s_and_b32 s76, s76, 255
s_lshl_b32 s76, s76, 13
s_add_u32 s77, s76, 0x1000
s_cmp_lg_u32 s43, 32
s_cbranch_scc1 L_yk
s_waitcnt vmcnt(8)
s_branch L_nok1
L_yk:
s_waitcnt vmcnt(8)
s_cbranch_execz L_nok1
buffer_load_dwordx4 v[180:183], v84, s[16:19], s76 offen offset:0 nt
buffer_load_dwordx4 v[184:187], v84, s[16:19], s76 offen offset:64 nt
buffer_load_dwordx4 v[188:191], v84, s[16:19], s76 offen offset:128 nt
buffer_load_dwordx4 v[192:195], v84, s[16:19], s76 offen offset:192 nt
buffer_load_dwordx4 v[196:199], v84, s[16:19], s77 offen offset:0 nt
buffer_load_dwordx4 v[200:203], v84, s[16:19], s77 offen offset:64 nt
buffer_load_dwordx4 v[204:207], v84, s[16:19], s77 offen offset:128 nt
buffer_load_dwordx4 v[208:211], v84, s[16:19], s77 offen offset:192 nt
L_nok1:
s_add_u32 s74, s74, 8
v_mfma_f32_16x16x32_bf16 v[52:55], v[212:215], v[4:7], 0
v_mfma_f32_16x16x32_bf16 v[56:59], v[228:231], v[4:7], 0
v_mfma_f32_16x16x32_bf16 v[52:55], v[216:219], v[8:11], v[52:55]
v_mfma_f32_16x16x32_bf16 v[56:59], v[232:235], v[8:11], v[56:59]
v_mfma_f32_16x16x32_bf16 v[52:55], v[220:223], v[12:15], v[52:55]
v_mfma_f32_16x16x32_bf16 v[56:59], v[236:239], v[12:15], v[56:59]
v_mfma_f32_16x16x32_bf16 v[52:55], v[224:227], v[16:19], v[52:55]
v_mfma_f32_16x16x32_bf16 v[56:59], v[240:243], v[16:19], v[56:59]
s_nop 6
v_max3_f32 v78, v52, v53, v54
v_max3_f32 v78, v78, v55, v76
v_max3_f32 v79, v56, v57, v58
v_max3_f32 v78, v78, v59, v79
v_mov_b32 v79, v78
s_nop 1
v_permlane32_swap_b32 v78, v79
v_max_f32 v78, v78, v79
v_mov_b32 v79, v78
s_nop 1
v_permlane16_swap_b32 v78, v79
v_max_f32 v76, v78, v79
v_mul_f32 v78, s52, v76
v_sub_f32 v80, v82, v78
v_mov_b32 v82, v78
v_exp_f32 v80, v80
v_fma_f32 v52, v52, s52, -v82
v_fma_f32 v53, v53, s52, -v82
v_fma_f32 v54, v54, s52, -v82
v_fma_f32 v55, v55, s52, -v82
v_fma_f32 v56, v56, s52, -v82
v_fma_f32 v57, v57, s52, -v82
v_fma_f32 v58, v58, s52, -v82
v_fma_f32 v59, v59, s52, -v82
L_ma1:
v_exp_f32 v52, v52
v_exp_f32 v53, v53
v_exp_f32 v54, v54
v_exp_f32 v55, v55
v_exp_f32 v56, v56
v_exp_f32 v57, v57
v_exp_f32 v58, v58
v_exp_f32 v59, v59
v_pk_mul_f32 v[20:21], v[20:21], v[80:81] op_sel_hi:[1,0]
v_pk_mul_f32 v[22:23], v[22:23], v[80:81] op_sel_hi:[1,0]
v_pk_mul_f32 v[24:25], v[24:25], v[80:81] op_sel_hi:[1,0]
v_pk_mul_f32 v[26:27], v[26:27], v[80:81] op_sel_hi:[1,0]
v_pk_mul_f32 v[28:29], v[28:29], v[80:81] op_sel_hi:[1,0]
v_pk_mul_f32 v[30:31], v[30:31], v[80:81] op_sel_hi:[1,0]
v_pk_mul_f32 v[32:33], v[32:33], v[80:81] op_sel_hi:[1,0]
v_pk_mul_f32 v[34:35], v[34:35], v[80:81] op_sel_hi:[1,0]
v_pk_mul_f32 v[36:37], v[36:37], v[80:81] op_sel_hi:[1,0]
v_pk_mul_f32 v[38:39], v[38:39], v[80:81] op_sel_hi:[1,0]
v_pk_mul_f32 v[40:41], v[40:41], v[80:81] op_sel_hi:[1,0]
v_pk_mul_f32 v[42:43], v[42:43], v[80:81] op_sel_hi:[1,0]
v_pk_mul_f32 v[44:45], v[44:45], v[80:81] op_sel_hi:[1,0]
v_pk_mul_f32 v[46:47], v[46:47], v[80:81] op_sel_hi:[1,0]
v_pk_mul_f32 v[48:49], v[48:49], v[80:81] op_sel_hi:[1,0]
v_pk_mul_f32 v[50:51], v[50:51], v[80:81] op_sel_hi:[1,0]
v_add_f32 v78, v52, v53
v_add_f32 v79, v54, v55
v_fma_f32 v77, v77, v80, v56
v_add_f32 v78, v78, v57
v_add_f32 v79, v79, v58
v_add_f32 v77, v77, v59
v_cvt_pk_bf16_f32 v60, v52, v53
v_cvt_pk_bf16_f32 v61, v54, v55
v_cvt_pk_bf16_f32 v62, v56, v57
v_cvt_pk_bf16_f32 v63, v58, v59
v_add_f32 v78, v78, v79
v_add_f32 v77, v77, v78
s_cmp_lg_u32 s43, 8
s_cbranch_scc1 L_nobar
s_barrier
L_nobar:
s_cmp_eq_u32 s43, 32
s_cbranch_scc1 L_last
s_cbranch_execz L_pv1
s_waitcnt vmcnt(8)
buffer_load_dwordx4 v[116:119], v88, s[20:23], s76 offen offset:0 nt
buffer_load_dwordx4 v[120:123], v88, s[20:23], s76 offen offset:1024 nt
buffer_load_dwordx4 v[124:127], v88, s[20:23], s76 offen offset:2048 nt
buffer_load_dwordx4 v[128:131], v88, s[20:23], s76 offen offset:3072 nt
buffer_load_dwordx4 v[132:135], v88, s[20:23], s77 offen offset:0 nt
buffer_load_dwordx4 v[136:139], v88, s[20:23], s77 offen offset:1024 nt
buffer_load_dwordx4 v[140:143], v88, s[20:23], s77 offen offset:2048 nt
buffer_load_dwordx4 v[144:147], v88, s[20:23], s77 offen offset:3072 nt
L_pv1:
v_perm_b32 v64, v152, v148, s50
v_perm_b32 v65, v160, v156, s50
v_perm_b32 v66, v168, v164, s50
v_perm_b32 v67, v176, v172, s50
v_perm_b32 v68, v152, v148, s51
v_perm_b32 v69, v160, v156, s51
v_perm_b32 v70, v168, v164, s51
v_perm_b32 v71, v176, v172, s51
v_mfma_f32_16x16x32_bf16 v[20:23], v[64:67], v[60:63], v[20:23]
v_perm_b32 v72, v153, v149, s50
v_perm_b32 v73, v161, v157, s50
v_perm_b32 v74, v169, v165, s50
v_perm_b32 v75, v177, v173, s50
v_mfma_f32_16x16x32_bf16 v[24:27], v[68:71], v[60:63], v[24:27]
v_perm_b32 v64, v153, v149, s51
v_perm_b32 v65, v161, v157, s51
v_perm_b32 v66, v169, v165, s51
v_perm_b32 v67, v177, v173, s51
v_mfma_f32_16x16x32_bf16 v[28:31], v[72:75], v[60:63], v[28:31]
L_mb1:
v_perm_b32 v68, v154, v150, s50
v_perm_b32 v69, v162, v158, s50
v_perm_b32 v70, v170, v166, s50
v_perm_b32 v71, v178, v174, s50
v_mfma_f32_16x16x32_bf16 v[32:35], v[64:67], v[60:63], v[32:35]
v_perm_b32 v72, v154, v150, s51
v_perm_b32 v73, v162, v158, s51
v_perm_b32 v74, v170, v166, s51
v_perm_b32 v75, v178, v174, s51
v_mfma_f32_16x16x32_bf16 v[36:39], v[68:71], v[60:63], v[36:39]
v_perm_b32 v64, v155, v151, s50
v_perm_b32 v65, v163, v159, s50
v_perm_b32 v66, v171, v167, s50
v_perm_b32 v67, v179, v175, s50
v_mfma_f32_16x16x32_bf16 v[40:43], v[72:75], v[60:63], v[40:43]
v_perm_b32 v68, v155, v151, s51
v_perm_b32 v69, v163, v159, s51
v_perm_b32 v70, v171, v167, s51
v_perm_b32 v71, v179, v175, s51
v_mfma_f32_16x16x32_bf16 v[44:47], v[64:67], v[60:63], v[44:47]
s_cmp_lt_u32 s43, 32
v_mfma_f32_16x16x32_bf16 v[48:51], v[68:71], v[60:63], v[48:51]
s_cbranch_scc1 L_loop
L_done:
s_cbranch_execz L_w2
v_permlane32_swap_b32 v20, v22
v_permlane32_swap_b32 v21, v23
v_permlane32_swap_b32 v24, v26
v_permlane32_swap_b32 v25, v27
ds_write2_b64 v96, v[22:23], v[26:27] offset0:0 offset1:1
v_permlane32_swap_b32 v28, v30
v_permlane32_swap_b32 v29, v31
v_permlane32_swap_b32 v32, v34
v_permlane32_swap_b32 v33, v35
ds_write2_b64 v96, v[30:31], v[34:35] offset0:128 offset1:129
v_add_u32 v96, 0x800, v96
v_permlane32_swap_b32 v36, v38
v_permlane32_swap_b32 v37, v39
v_permlane32_swap_b32 v40, v42
v_permlane32_swap_b32 v41, v43
ds_write2_b64 v96, v[38:39], v[42:43] offset0:0 offset1:1
v_permlane32_swap_b32 v44, v46
v_permlane32_swap_b32 v45, v47
v_permlane32_swap_b32 v48, v50
v_permlane32_swap_b32 v49, v51
ds_write2_b64 v96, v[46:47], v[50:51] offset0:128 offset1:129
s_waitcnt lgkmcnt(0)
s_barrier
ds_read_b128 v[4:7], v97 offset:0
ds_read_b128 v[8:11], v97 offset:1024
ds_read_b128 v[12:15], v97 offset:2048
ds_read_b128 v[16:19], v97 offset:3072
L_w2:
v_pk_mul_f32 v[180:181], v[20:21], v[104:105] op_sel_hi:[1,0]
v_pk_mul_f32 v[182:183], v[24:25], v[104:105] op_sel_hi:[1,0]
v_pk_mul_f32 v[184:185], v[28:29], v[104:105] op_sel_hi:[1,0]
v_pk_mul_f32 v[186:187], v[32:33], v[104:105] op_sel_hi:[1,0]
v_pk_mul_f32 v[188:189], v[36:37], v[104:105] op_sel_hi:[1,0]
v_pk_mul_f32 v[190:191], v[40:41], v[104:105] op_sel_hi:[1,0]
v_pk_mul_f32 v[192:193], v[44:45], v[104:105] op_sel_hi:[1,0]
v_pk_mul_f32 v[194:195], v[48:49], v[104:105] op_sel_hi:[1,0]
s_cmp_eq_u32 s55, 0
s_waitcnt lgkmcnt(3)
v_pk_fma_f32 v[180:181], v[4:5], v[106:107], v[180:181] op_sel_hi:[1,0,1]
v_pk_fma_f32 v[182:183], v[6:7], v[106:107], v[182:183] op_sel_hi:[1,0,1]
s_waitcnt lgkmcnt(2)
v_pk_fma_f32 v[184:185], v[8:9], v[106:107], v[184:185] op_sel_hi:[1,0,1]
v_pk_fma_f32 v[186:187], v[10:11], v[106:107], v[186:187] op_sel_hi:[1,0,1]
s_waitcnt lgkmcnt(1)
v_pk_fma_f32 v[188:189], v[12:13], v[106:107], v[188:189] op_sel_hi:[1,0,1]
v_pk_fma_f32 v[190:191], v[14:15], v[106:107], v[190:191] op_sel_hi:[1,0,1]
s_waitcnt lgkmcnt(0)
v_pk_fma_f32 v[192:193], v[16:17], v[106:107], v[192:193] op_sel_hi:[1,0,1]
v_pk_fma_f32 v[194:195], v[18:19], v[106:107], v[194:195] op_sel_hi:[1,0,1]
s_cbranch_scc0 L_comb
v_cvt_pk_bf16_f32 v20, v180, v181
v_cvt_pk_bf16_f32 v21, v182, v183
v_cvt_pk_bf16_f32 v22, v184, v185
v_cvt_pk_bf16_f32 v23, v186, v187
v_min_u32 v20, s53, v20
v_min_u32 v21, s53, v21
v_min_u32 v22, s53, v22
v_min_u32 v23, s53, v23
s_cbranch_execz L_comb
buffer_store_dwordx4 v[20:23], v101, s[32:35], s88 offen offset:0 sc1
v_cvt_pk_bf16_f32 v24, v188, v189
v_cvt_pk_bf16_f32 v25, v190, v191
v_cvt_pk_bf16_f32 v26, v192, v193
v_cvt_pk_bf16_f32 v27, v194, v195
v_min_u32 v24, s53, v24
v_min_u32 v25, s53, v25
v_min_u32 v26, s53, v26
v_min_u32 v27, s53, v27
buffer_store_dwordx4 v[24:27], v101, s[32:35], s88 offen offset:1024 sc1
s_branch L_fin
L_again:
s_add_u32 s43, s43, 1
s_cmp_gt_u32 s43, 0x40000
s_cbranch_scc1 L_fin
buffer_load_dwordx2 v[110:111], v102, s[32:35], s89 offen sc1
buffer_load_dwordx4 v[196:199], v101, s[32:35], s89 offen offset:0 sc1
buffer_load_dwordx4 v[200:203], v101, s[32:35], s89 offen offset:1024 sc1
buffer_load_dwordx2 v[112:113], v102, s[32:35], s90 offen sc1
buffer_load_dwordx4 v[204:207], v101, s[32:35], s90 offen offset:0 sc1
buffer_load_dwordx4 v[208:211], v101, s[32:35], s90 offen offset:1024 sc1
buffer_load_dwordx2 v[114:115], v102, s[32:35], s91 offen sc1
buffer_load_dwordx4 v[212:215], v101, s[32:35], s91 offen offset:0 sc1
buffer_load_dwordx4 v[216:219], v101, s[32:35], s91 offen offset:1024 sc1
L_comb:
s_waitcnt vmcnt(0)
v_max3_u32 v78, v110, v111, v112
v_max3_u32 v79, v113, v114, v115
v_max3_u32 v78, v78, v196, v197
v_max3_u32 v79, v79, v198, v199
v_max3_u32 v78, v78, v200, v201
v_max3_u32 v79, v79, v202, v203
v_max3_u32 v78, v78, v204, v205
v_max3_u32 v79, v79, v206, v207
v_max3_u32 v78, v78, v208, v209
v_max3_u32 v79, v79, v210, v211
v_max3_u32 v78, v78, v212, v213
v_max3_u32 v79, v79, v214, v215
v_max3_u32 v78, v78, v216, v217
v_max3_u32 v79, v79, v218, v219
v_max_u32 v78, v78, v79
v_cmp_eq_u32 vcc, -1, v78
s_cbranch_vccnz L_again
v_max_f32 v78, v108, v110
v_max3_f32 v78, v78, v112, v114
v_sub_f32 v108, v108, v78
v_sub_f32 v110, v110, v78
v_sub_f32 v112, v112, v78
v_sub_f32 v114, v114, v78
v_exp_f32 v108, v108
v_exp_f32 v110, v110
v_exp_f32 v112, v112
v_exp_f32 v114, v114
s_nop 0
v_mul_f32 v79, v108, v109
v_fmac_f32 v79, v110, v111
v_fmac_f32 v79, v112, v113
v_fmac_f32 v79, v114, v115
v_rcp_f32 v78, v79
s_nop 0
v_mul_f32 v108, v78, v108
v_mul_f32 v110, v78, v110
v_mul_f32 v112, v78, v112
v_mul_f32 v114, v78, v114
v_pk_mul_f32 v[180:181], v[180:181], v[108:109] op_sel_hi:[1,0]
v_pk_mul_f32 v[182:183], v[182:183], v[108:109] op_sel_hi:[1,0]
v_pk_mul_f32 v[184:185], v[184:185], v[108:109] op_sel_hi:[1,0]
v_pk_mul_f32 v[186:187], v[186:187], v[108:109] op_sel_hi:[1,0]
v_pk_mul_f32 v[188:189], v[188:189], v[108:109] op_sel_hi:[1,0]
v_pk_mul_f32 v[190:191], v[190:191], v[108:109] op_sel_hi:[1,0]
v_pk_mul_f32 v[192:193], v[192:193], v[108:109] op_sel_hi:[1,0]
v_pk_mul_f32 v[194:195], v[194:195], v[108:109] op_sel_hi:[1,0]
L_c1:
v_lshlrev_b32 v20, 16, v196
v_and_b32 v21, 0xffff0000, v196
v_lshlrev_b32 v22, 16, v197
v_and_b32 v23, 0xffff0000, v197
v_lshlrev_b32 v24, 16, v198
v_and_b32 v25, 0xffff0000, v198
v_lshlrev_b32 v26, 16, v199
v_and_b32 v27, 0xffff0000, v199
v_lshlrev_b32 v28, 16, v200
v_and_b32 v29, 0xffff0000, v200
v_lshlrev_b32 v30, 16, v201
v_and_b32 v31, 0xffff0000, v201
v_lshlrev_b32 v32, 16, v202
v_and_b32 v33, 0xffff0000, v202
v_lshlrev_b32 v34, 16, v203
v_and_b32 v35, 0xffff0000, v203
v_pk_fma_f32 v[180:181], v[20:21], v[110:111], v[180:181] op_sel_hi:[1,0,1]
v_pk_fma_f32 v[182:183], v[22:23], v[110:111], v[182:183] op_sel_hi:[1,0,1]
v_pk_fma_f32 v[184:185], v[24:25], v[110:111], v[184:185] op_sel_hi:[1,0,1]
v_pk_fma_f32 v[186:187], v[26:27], v[110:111], v[186:187] op_sel_hi:[1,0,1]
v_pk_fma_f32 v[188:189], v[28:29], v[110:111], v[188:189] op_sel_hi:[1,0,1]
v_pk_fma_f32 v[190:191], v[30:31], v[110:111], v[190:191] op_sel_hi:[1,0,1]
v_pk_fma_f32 v[192:193], v[32:33], v[110:111], v[192:193] op_sel_hi:[1,0,1]
v_pk_fma_f32 v[194:195], v[34:35], v[110:111], v[194:195] op_sel_hi:[1,0,1]
L_c2:
v_lshlrev_b32 v20, 16, v204
v_and_b32 v21, 0xffff0000, v204
v_lshlrev_b32 v22, 16, v205
v_and_b32 v23, 0xffff0000, v205
v_lshlrev_b32 v24, 16, v206
v_and_b32 v25, 0xffff0000, v206
v_lshlrev_b32 v26, 16, v207
v_and_b32 v27, 0xffff0000, v207
v_lshlrev_b32 v28, 16, v208
v_and_b32 v29, 0xffff0000, v208
v_lshlrev_b32 v30, 16, v209
v_and_b32 v31, 0xffff0000, v209
v_lshlrev_b32 v32, 16, v210
v_and_b32 v33, 0xffff0000, v210
v_lshlrev_b32 v34, 16, v211
v_and_b32 v35, 0xffff0000, v211
v_pk_fma_f32 v[180:181], v[20:21], v[112:113], v[180:181] op_sel_hi:[1,0,1]
v_pk_fma_f32 v[182:183], v[22:23], v[112:113], v[182:183] op_sel_hi:[1,0,1]
v_pk_fma_f32 v[184:185], v[24:25], v[112:113], v[184:185] op_sel_hi:[1,0,1]
v_pk_fma_f32 v[186:187], v[26:27], v[112:113], v[186:187] op_sel_hi:[1,0,1]
v_pk_fma_f32 v[188:189], v[28:29], v[112:113], v[188:189] op_sel_hi:[1,0,1]
v_pk_fma_f32 v[190:191], v[30:31], v[112:113], v[190:191] op_sel_hi:[1,0,1]
v_pk_fma_f32 v[192:193], v[32:33], v[112:113], v[192:193] op_sel_hi:[1,0,1]
v_pk_fma_f32 v[194:195], v[34:35], v[112:113], v[194:195] op_sel_hi:[1,0,1]
L_c3:
v_lshlrev_b32 v20, 16, v212
v_and_b32 v21, 0xffff0000, v212
v_lshlrev_b32 v22, 16, v213
v_and_b32 v23, 0xffff0000, v213
v_lshlrev_b32 v24, 16, v214
v_and_b32 v25, 0xffff0000, v214
v_lshlrev_b32 v26, 16, v215
v_and_b32 v27, 0xffff0000, v215
v_lshlrev_b32 v28, 16, v216
v_and_b32 v29, 0xffff0000, v216
v_lshlrev_b32 v30, 16, v217
v_and_b32 v31, 0xffff0000, v217
v_lshlrev_b32 v32, 16, v218
v_and_b32 v33, 0xffff0000, v218
v_lshlrev_b32 v34, 16, v219
v_and_b32 v35, 0xffff0000, v219
v_pk_fma_f32 v[180:181], v[20:21], v[114:115], v[180:181] op_sel_hi:[1,0,1]
v_pk_fma_f32 v[182:183], v[22:23], v[114:115], v[182:183] op_sel_hi:[1,0,1]
v_pk_fma_f32 v[184:185], v[24:25], v[114:115], v[184:185] op_sel_hi:[1,0,1]
v_pk_fma_f32 v[186:187], v[26:27], v[114:115], v[186:187] op_sel_hi:[1,0,1]
v_pk_fma_f32 v[188:189], v[28:29], v[114:115], v[188:189] op_sel_hi:[1,0,1]
v_pk_fma_f32 v[190:191], v[30:31], v[114:115], v[190:191] op_sel_hi:[1,0,1]
v_pk_fma_f32 v[192:193], v[32:33], v[114:115], v[192:193] op_sel_hi:[1,0,1]
v_pk_fma_f32 v[194:195], v[34:35], v[114:115], v[194:195] op_sel_hi:[1,0,1]
v_cvt_pk_bf16_f32 v20, v180, v182
v_cvt_pk_bf16_f32 v21, v184, v186
v_cvt_pk_bf16_f32 v22, v188, v190
v_cvt_pk_bf16_f32 v23, v192, v194
v_cvt_pk_bf16_f32 v24, v181, v183
v_cvt_pk_bf16_f32 v25, v185, v187
v_cvt_pk_bf16_f32 v26, v189, v191
v_cvt_pk_bf16_f32 v27, v193, v195
v_permlane16_swap_b32 v20, v24
v_permlane16_swap_b32 v21, v25
v_permlane16_swap_b32 v22, v26
v_permlane16_swap_b32 v23, v27
s_cbranch_execz L_hret
buffer_store_dwordx4 v[20:23], v103, s[28:31], 0 offen offset:0 sc1
buffer_store_dwordx4 v[24:27], v103, s[28:31], 0 offen offset:64 sc1
L_fin:
L_end:
s_endpgm
L_last:
v_mov_b32 v79, v77
s_nop 1
v_permlane32_swap_b32 v77, v79
v_add_f32 v77, v77, v79
v_mov_b32 v79, v77
s_nop 1
v_permlane16_swap_b32 v77, v79
v_add_f32 v83, v77, v79
s_cbranch_execz L_done
ds_write_b64 v98, v[82:83]
s_cmp_lg_u32 s42, 0
s_cbranch_scc1 L_nofl
s_mov_b64 exec, 1
ds_write_b32 v100, v95
s_mov_b64 exec, -1
L_nofl:
s_waitcnt lgkmcnt(0)
s_barrier
ds_read_b32 v94, v100
ds_read_b64 v[106:107], v99
s_waitcnt lgkmcnt(0)
v_readfirstlane_b32 s55, v94
v_max_f32 v108, v82, v106
v_sub_f32 v104, v82, v108
v_sub_f32 v106, v106, v108
v_exp_f32 v104, v104
v_exp_f32 v106, v106
s_nop 0
v_mul_f32 v109, v104, v83
v_fmac_f32 v109, v106, v107
s_cmp_eq_u32 s55, 3
s_cselect_b32 s55, 1, 0
s_waitcnt vmcnt(0)
s_cbranch_scc1 L_lc
s_cmp_lg_u32 s42, 0
s_cbranch_scc1 L_lj
v_min_u32 v108, s53, v108
v_min_u32 v109, s53, v109
buffer_store_dwordx2 v[108:109], v102, s[32:35], s88 offen sc1
s_branch L_lj
L_lc:
buffer_load_dwordx2 v[110:111], v102, s[32:35], s89 offen sc1
buffer_load_dwordx4 v[196:199], v101, s[32:35], s89 offen offset:0 sc1
buffer_load_dwordx4 v[200:203], v101, s[32:35], s89 offen offset:1024 sc1
buffer_load_dwordx2 v[112:113], v102, s[32:35], s90 offen sc1
buffer_load_dwordx4 v[204:207], v101, s[32:35], s90 offen offset:0 sc1
buffer_load_dwordx4 v[208:211], v101, s[32:35], s90 offen offset:1024 sc1
buffer_load_dwordx2 v[114:115], v102, s[32:35], s91 offen sc1
buffer_load_dwordx4 v[212:215], v101, s[32:35], s91 offen offset:0 sc1
buffer_load_dwordx4 v[216:219], v101, s[32:35], s91 offen offset:1024 sc1
L_lj:
s_branch L_pv1
L_helper:
v_lshlrev_b32 v89, 4, v0
s_mul_i32 s49, s40, 20480
s_mov_b32 s35, 0x20000
s_mov_b32 s34, 20480
v_mov_b32 v84, 0
v_mov_b32 v88, 0
v_mov_b32 v100, 0
v_mov_b32 v101, 0
v_mov_b32 v102, 0
v_mov_b32 v103, 0
v_mov_b32 v96, 0
v_mov_b32 v97, 0
v_mov_b32 v98, 0
v_mov_b32 v99, 0
s_mov_b64 s[32:33], s[0:1]
s_mov_b64 s[16:17], s[0:1]
s_mov_b64 s[18:19], 0
s_mov_b64 s[20:21], s[0:1]
s_mov_b64 s[22:23], 0
s_mov_b64 s[28:29], s[0:1]
s_mov_b64 s[30:31], 0
s_mov_b64 s[84:85], s[0:1]
s_mov_b64 s[86:87], 0
s_mov_b32 s43, 40
s_mov_b32 s55, 0
s_mov_b64 s[74:75], 0
s_mov_b64 s[76:77], 0
s_mov_b64 s[82:83], 0
s_mov_b64 s[88:89], 0
s_mov_b64 s[90:91], 0
s_mov_b64 vcc, 0
s_mov_b64 exec, 0
s_bfe_u32 s44, s2, 0x30003
s_cmp_eq_u32 s44, 1
s_cbranch_scc1 L_p2
s_cmp_eq_u32 s44, 2
s_cbranch_scc1 L_pv0
s_cmp_eq_u32 s44, 3
s_cbranch_scc1 L_nok1
s_cmp_eq_u32 s44, 4
s_cbranch_scc1 L_pv1
s_cmp_eq_u32 s44, 5
s_cbranch_scc1 L_last
s_cmp_eq_u32 s44, 6
s_cbranch_scc1 L_comb
s_cmp_eq_u32 s44, 7
s_cbranch_scc1 L_c2
L_hmid:
s_mov_b32 s43, 40
s_branch L_nok0
L_hret:
s_mov_b64 exec, -1
s_mul_i32 s88, s41, 5120
v_mov_b32 v4, -1
v_mov_b32 v5, -1
v_mov_b32 v6, -1
v_mov_b32 v7, -1
s_waitcnt lgkmcnt(0)
s_add_u32 s32, s14, s49
s_addc_u32 s33, s15, 0
buffer_store_dwordx4 v[4:7], v89, s[32:35], s88 offen offset:0 sc1
buffer_store_dwordx4 v[4:7], v89, s[32:35], s88 offen offset:1024 sc1
buffer_store_dwordx4 v[4:7], v89, s[32:35], s88 offen offset:2048 sc1
buffer_store_dwordx4 v[4:7], v89, s[32:35], s88 offen offset:3072 sc1
s_add_u32 s88, s88, 0x1000
v_lshlrev_b32 v8, 2, v0
buffer_store_dword v4, v8, s[32:35], s88 offen sc1
s_waitcnt vmcnt(0)
s_barrier
s_endpgm
.section .rodata,"a"
.p2align 6
.amdhsa_kernel standalone__gqa_softmax__sampling_kernel
  .amdhsa_next_free_vgpr 244
  .amdhsa_next_free_sgpr 96
  .amdhsa_accum_offset 244
  .amdhsa_group_segment_fixed_size 0
  .amdhsa_kernarg_size 48
  .amdhsa_user_sgpr_count 2
  .amdhsa_user_sgpr_kernarg_segment_ptr 1
  .amdhsa_system_sgpr_workgroup_id_x 1
.end_amdhsa_kernel
```
